```python
import torch

def _softmax(x, axis=-1):
    return torch.softmax(x, dim=axis)
def _gelu(x):
    return torch.nn.functional.gelu(x, approximate="tanh")
def _silu(x):
    return torch.nn.functional.silu(x)
def _sigmoid(x):
    return torch.sigmoid(x)
def _layernorm(x, axis=-1, eps=1e-5):
    m = x.mean(dim=axis, keepdim=True)
    v = x.var(dim=axis, keepdim=True, unbiased=False)
    return (x - m) / torch.sqrt(v + eps)
def _scatter_add(tgt, idx, src, axis=0):
    return tgt.clone().index_add_(axis, idx, src)
def _segment_sum(src, seg, n):
    out = torch.zeros((n,) + src.shape[1:], dtype=src.dtype)
    return out.index_add_(0, seg, src)
def _pad(x, pw):
    flat = tuple(v for pair in reversed(pw) for v in pair)
    return torch.nn.functional.pad(x, flat)

kernel_name = 'interleave_layers__sliding_block_cached__dense_activation_silu__decode'

def setup_inputs():

    _w = (lambda a: (lambda t: t.to(torch.bfloat16) if t.is_floating_point() else t)(torch.as_tensor(a)))
    def _A_setup():
        B, Sq, D = 8, 1, 1024
        Hq, Hkv, Sk, Dh = 32, 4, 4096, 128
        assert Hq % Hkv == 0, (Hq, Hkv)
        return {
            "x": _w((lambda *s: torch.randn(*s, dtype=torch.bfloat16) * 0.05)(B, Sq, D)),
            "k_cache": _w((lambda *s: torch.randn(*s, dtype=torch.bfloat16) * 0.8)(B, Hkv, Sk, Dh)),
            "v_cache": _w((lambda *s: torch.randn(*s, dtype=torch.bfloat16) * 1.6)(B, Hkv, Sk, Dh)),
            "wq": _w((lambda *s: torch.randn(*s, dtype=torch.bfloat16) * 0.8)(D, Hq * Dh) * (D ** -0.5)),
            "wo": _w((lambda *s: torch.randn(*s, dtype=torch.bfloat16) * 1.6)(Hq * Dh, D) * ((Hq * Dh) ** -0.5)),
        }
    _A_in = _A_setup()

    def _B_setup():
        B, S, D, F = 8, 1, 1024, 3584
        return {
            "x": _w((lambda *s: torch.randn(*s, dtype=torch.bfloat16) * 0.05)(B, S, D)),
            "w1": _w((lambda *s: torch.randn(*s, dtype=torch.bfloat16) * 1.6)(D, F) * (D ** -0.5)),
            "w2": _w((lambda *s: torch.randn(*s, dtype=torch.bfloat16) * 0.2)(F, D) * (F ** -0.5)),
        }
    _B_in = _B_setup()

    return {
        "A_x": _A_in["x"],
        "A_k_cache": _A_in["k_cache"],
        "A_v_cache": _A_in["v_cache"],
        "A_wq": _A_in["wq"],
        "A_wo": _A_in["wo"],
        "B_x": _B_in["x"],
        "B_w1": _B_in["w1"],
        "B_w2": _B_in["w2"],
    }

def reference(A_x, A_k_cache, A_v_cache, A_wq, A_wo, B_x, B_w1, B_w2):
    def _A_ref(x, k_cache, v_cache, wq, wo):
        B, Sq, D = x.shape
        Hq, Dh = 32, 128
        Hkv, Sk = k_cache.shape[1], k_cache.shape[2]
        W = min(4096, max(256, Sk // 4))
        rep = Hq // Hkv
        q = (lambda x, *d: x.permute(*d))((x @ wq).reshape(B, Sq, Hq, Dh), 0, 2, 1, 3)
        k = (lambda x, n, axis: torch.repeat_interleave(x, n, dim=axis))(k_cache[:, :, Sk - W:, :], rep, axis=1)
        v = (lambda x, n, axis: torch.repeat_interleave(x, n, dim=axis))(v_cache[:, :, Sk - W:, :], rep, axis=1)
        scores = torch.einsum("bhqd,bhkd->bhqk", q, k) * (Dh ** -0.5)
        p = _softmax(scores, axis=-1)
        o = torch.einsum("bhqk,bhkd->bhqd", p, v)
        return (lambda x, *d: x.permute(*d))(o, 0, 2, 1, 3).reshape(B, Sq, Hq * Dh) @ wo

    def _B_ref(x, w1, w2):
        h = torch.einsum("bsd,df->bsf", x, w1)
        h = _silu(h)
        out = torch.einsum("bsf,fd->bsd", h, w2)
        return out

    x = A_x
    x = x + _A_ref(_layernorm(x, axis=-1), A_k_cache, A_v_cache, A_wq, A_wo)
    x = x + _B_ref(_layernorm(x, axis=-1), B_w1, B_w2)
    x = x + _A_ref(_layernorm(x, axis=-1), A_k_cache, A_v_cache, A_wq, A_wo)
    x = x + _B_ref(_layernorm(x, axis=-1), B_w1, B_w2)
    return x
```

```asm
; @launch grid=(256,1,1) block=(512,1,1) lds=140800
.amdgcn_target "amdgcn-amd-amdhsa--gfx950"
.text
.globl interleave_layers__sliding_block_cached__dense_activation_silu__decode_kernel
.p2align 8
.type interleave_layers__sliding_block_cached__dense_activation_silu__decode_kernel,@function
interleave_layers__sliding_block_cached__dense_activation_silu__decode_kernel:
    s_cmp_ge_u32 s2, 256
    s_cbranch_scc1 L_exit
    s_load_dwordx16 s[72:87], s[0:1], 0
    s_load_dwordx2 s[88:89], s[0:1], 64
    s_load_dwordx2 s[90:91], s[0:1], 80
    v_lshrrev_b32 v1, 6, v0
    v_and_b32 v2, 63, v0
    v_lshrrev_b32 v3, 4, v2
    v_readfirstlane_b32 s40, v1
    v_and_b32 v4, 15, v2
    v_and_b32 v5, 7, v2
    v_bfe_u32 v6, v2, 3, 1
    s_and_b32 s92, s2, 7
    s_lshr_b32 s93, s2, 3
    s_lshr_b32 s94, s92, 1
    s_and_b32 s95, s92, 1
    s_lshl_b32 s95, s95, 5
    s_add_u32 s95, s95, s93
    s_lshl_b32 s66, s40, 12
    s_mov_b32 s41, 0
    s_mov_b32 s43, 0x40000
    s_movk_i32 s44, 0xff
    s_mov_b32 s68, 0x00ff00ff
    s_mov_b32 s69, 0x00ff00ff
    s_movk_i32 s70, 0xff
    s_movk_i32 s71, 0xff
    s_mov_b32 s65, 0x3e0293ee

    s_mov_b32 s10, 16384
    s_mov_b32 s11, 0x20000
    s_mov_b32 s14, 33554432
    s_mov_b32 s15, 0x20000
    s_mov_b32 s18, 33554432
    s_mov_b32 s19, 0x20000
    s_mov_b32 s22, 8388608
    s_mov_b32 s23, 0x20000
    s_mov_b32 s26, 8388608
    s_mov_b32 s27, 0x20000
    s_mov_b32 s30, 7340032
    s_mov_b32 s31, 0x20000
    s_mov_b32 s34, 7340032
    s_mov_b32 s35, 0x20000
    s_mov_b32 s38, 16384
    s_mov_b32 s39, 0x20000
    s_mov_b32 s6, 16777216
    s_mov_b32 s7, 0x20000
    v_lshlrev_b32 v7, 11, v5
    v_lshl_add_u32 v7, v6, 6, v7
    v_lshl_add_u32 v7, v3, 4, v7
    v_and_b32 v8, 1, v3
    v_lshlrev_b32 v8, 1, v8
    v_xor_b32 v8, v8, v5
    v_lshlrev_b32 v8, 4, v8
    v_lshrrev_b32 v9, 3, v2
    v_lshl_add_u32 v10, v9, 13, v8
    v_xor_b32 v11, 64, v10
    v_mul_u32_u24 v179, 7168, v9
    v_add_u32 v180, v179, v8
    v_xor_b32 v8, 64, v8
    v_add_u32 v179, v179, v8
    s_and_b32 s96, s95, 3
    s_lshr_b32 s97, s95, 2
    s_lshl_b32 s98, s94, 4
    s_add_u32 s97, s97, s98
    s_sub_u32 s98, s40, 4
    s_cmp_lt_u32 s40, 4
    s_cselect_b32 s98, s96, s98
    s_lshl_b32 s46, s98, 9
    s_lshl_b32 s99, s96, 8
    s_lshl_b32 s100, s40, 5
    s_add_u32 s99, s99, s100
    s_lshl_b32 s99, s99, 13
    s_lshl_b32 s100, s97, 7
    s_add_u32 s61, s99, s100
    s_waitcnt lgkmcnt(0)
    s_load_dword s42, s[90:91], 0

    s_mov_b32 s8, s72
    s_mov_b32 s9, s73
    s_mov_b32 s12, s74
    s_mov_b32 s13, s75
    s_mov_b32 s16, s76
    s_mov_b32 s17, s77
    s_mov_b32 s20, s78
    s_mov_b32 s21, s79
    s_mov_b32 s24, s80
    s_mov_b32 s25, s81
    s_mov_b32 s28, s84
    s_mov_b32 s29, s85
    s_mov_b32 s32, s86
    s_mov_b32 s33, s87
    s_mov_b32 s36, s88
    s_mov_b32 s37, s89
    s_mov_b32 s4, s90
    s_mov_b32 s5, s91
    s_add_u32 m0, s66, 0
    s_add_u32 s60, s61, 0
    buffer_load_dwordx4 v10, s[20:23], s60 offen nt lds
    s_add_u32 m0, s66, 1024
    s_add_u32 s60, s61, 65536
    buffer_load_dwordx4 v11, s[20:23], s60 offen nt lds
    s_add_u32 m0, s66, 2048
    s_add_u32 s60, s61, 131072
    buffer_load_dwordx4 v10, s[20:23], s60 offen nt lds
    s_add_u32 m0, s66, 3072
    s_add_u32 s60, s61, 196608
    buffer_load_dwordx4 v11, s[20:23], s60 offen nt lds
    buffer_load_dwordx4 v[186:189], v7, s[8:11], s46 offen offset:0
    buffer_load_dwordx4 v[190:193], v7, s[8:11], s46 offen offset:128
    buffer_load_dwordx4 v[194:197], v7, s[8:11], s46 offen offset:256
    buffer_load_dwordx4 v[198:201], v7, s[8:11], s46 offen offset:384
    s_lshr_b32 s72, s95, 3
    s_and_b32 s73, s95, 7
    s_lshl_b32 s74, s72, 2
    s_add_u32 s74, s74, s94
    s_lshl_b32 s75, s74, 20
    s_lshl_b32 s76, s73, 15
    s_add_u32 s75, s75, s76
    s_and_b32 s76, s40, 3
    s_lshl_b32 s88, s76, 13
    s_add_u32 s75, s75, s88
    s_add_u32 s89, s75, 786432
    v_lshlrev_b32 v12, 8, v4
    v_lshl_add_u32 v181, v3, 4, v12
    v_lshlrev_b32 v13, 1, v3
    v_xor_b32 v13, v13, v4
    v_lshlrev_b32 v13, 4, v13
    v_lshl_add_u32 v182, v3, 8, v13
    v_xor_b32 v183, 0x80, v182
    v_lshl_add_u32 v176, v3, 11, v13
    v_xor_b32 v177, 0x80, v176

    s_lshl_b32 s46, s98, 12
    s_add_u32 s46, s46, -245760
    s_lshr_b32 s76, s97, 1
    s_and_b32 s77, s76, 7
    s_lshl_b32 s77, s77, 11
    s_lshl_b32 s78, s94, 14
    s_add_u32 s77, s77, s78
    s_lshl_b32 s78, s96, 9
    s_and_b32 s79, s97, 1
    s_lshl_b32 s79, s79, 8
    s_add_u32 s78, s78, s79
    s_add_u32 s77, s77, s78
    s_add_u32 s48, s77, 65536
    s_lshl_b32 s76, s76, 11
    s_add_u32 s76, s76, s78
    s_add_u32 s82, s76, 3997696
    s_lshl_b32 s50, s74, 14
    s_add_u32 s50, s50, 65536
    s_lshl_b32 s83, s94, 14
    s_add_u32 s83, s83, 3997696
    s_mul_i32 s76, s94, 147456
    s_add_u32 s76, s76, 589824
    s_lshl_b32 s77, s95, 8
    s_add_u32 s52, s76, s77
    s_lshl_b32 s77, s72, 14
    s_add_u32 s53, s76, s77
    s_lshl_b32 s76, s94, 3
    s_add_u32 s76, s76, s72
    s_lshl_b32 s77, s73, 17
    s_lshl_b32 s78, s76, 7
    s_add_u32 s77, s77, s78
    s_add_u32 s54, s77, 1376256
    s_and_b32 s76, s72, 1
    s_lshl_b32 s76, s76, 2
    s_lshl_b32 s77, s94, 3
    s_add_u32 s76, s76, s77
    s_lshr_b32 s77, s40, 1
    s_add_u32 s76, s76, s77
    s_lshl_b32 s76, s76, 3
    s_and_b32 s77, s72, 6
    s_add_u32 s76, s76, s77
    s_and_b32 s77, s40, 1
    s_add_u32 s76, s76, s77
    s_lshl_b32 s76, s76, 15
    s_lshl_b32 s78, s73, 8
    s_add_u32 s62, s76, s78
    s_lshl_b32 s76, s92, 5
    s_add_u32 s76, s76, s93
    s_lshl_b32 s77, s76, 12
    s_add_u32 s56, s77, 1376256
    s_add_u32 s57, s77, 2883584
    s_lshl_b32 s77, s76, 6
    s_add_u32 s58, s77, 3932160
    s_add_u32 s59, s77, 3948544
    s_and_b32 s84, s76, 1
    s_lshl_b32 s84, s84, 13
    s_lshr_b32 s85, s76, 1
    s_lshl_b32 s85, s85, 4
    s_add_u32 s84, s84, s85
    s_cmp_lt_u32 s93, 28
    s_cselect_b32 s45, 1, 0
    s_cselect_b32 s67, -1, 1
    s_min_u32 s76, s93, 27
    s_mul_i32 s77, s92, 28
    s_add_u32 s76, s76, s77
    s_and_b32 s77, s76, 3
    s_lshr_b32 s78, s76, 2
    s_sub_u32 s79, s40, 4
    s_cmp_lt_u32 s40, 4
    s_cselect_b32 s79, s77, s79
    s_lshl_b32 s79, s79, 12
    s_add_u32 s47, s79, 3932160
    s_lshl_b32 s79, s77, 8
    s_lshl_b32 s80, s40, 5
    s_add_u32 s79, s79, s80
    s_mul_i32 s79, s79, 7168
    s_lshl_b32 s80, s78, 7
    s_add_u32 s63, s79, s80
    s_lshl_b32 s79, s77, 9
    s_and_b32 s80, s78, 1
    s_lshl_b32 s80, s80, 8
    s_add_u32 s79, s79, s80
    s_lshr_b32 s80, s78, 1
    s_lshl_b32 s81, s80, 14
    s_add_u32 s51, s81, 2424832
    s_add_u32 s49, s51, s79
    s_lshl_b32 s81, s80, 11
    s_add_u32 s87, s81, 4063232
    s_add_u32 s86, s87, s79
    s_and_b32 s77, s76, 7
    s_lshl_b32 s78, s77, 17
    s_lshl_b32 s79, s80, 7
    s_add_u32 s78, s78, s79
    s_add_u32 s55, s78, 2883584
    s_lshl_b32 s78, s80, 18
    s_lshl_b32 s79, s77, 8
    s_add_u32 s78, s78, s79
    s_lshl_b32 s79, s40, 15
    s_add_u32 s64, s78, s79

    v_mov_b32 v202, -1
    v_mov_b32 v203, -1
    v_mov_b32 v204, -1
    v_mov_b32 v205, -1
    v_lshlrev_b32 v169, 4, v2
    s_lshr_b32 s76, s40, 1
    s_lshl_b32 s76, s76, 8
    s_and_b32 s77, s40, 1
    s_add_u32 s76, s76, s77
    s_lshl_b32 s76, s76, 7
    v_lshl_add_u32 v7, v3, 3, s76
    v_lshrrev_b32 v8, 2, v5
    v_lshl_add_u32 v7, v8, 14, v7
    v_and_b32 v8, 3, v5
    v_lshl_add_u32 v165, v8, 5, v7
    s_add_u32 s77, s52, 4194304
    s_mov_b64 exec, s[68:69]
    buffer_store_dwordx2 v[202:203], v165, s[4:7], s52 offen sc1
    buffer_store_dwordx2 v[202:203], v165, s[4:7], s77 offen sc1
    s_cmp_lg_u32 s40, 0
    s_cbranch_scc1 L_noclr
    s_mov_b64 exec, 3
    s_add_u32 s76, s52, 131072
    s_add_u32 s77, s77, 131072
    buffer_store_dwordx4 v[202:205], v169, s[4:7], s76 offen sc1
    buffer_store_dwordx4 v[202:205], v169, s[4:7], s77 offen sc1
    s_mov_b64 exec, 0xf
    s_mov_b32 s76, s59
    s_add_u32 s77, s58, 4194304
    buffer_store_dwordx4 v[202:205], v169, s[4:7], s58 offen sc1
    buffer_store_dwordx4 v[202:205], v169, s[4:7], s76 offen sc1
    buffer_store_dwordx4 v[202:205], v169, s[4:7], s77 offen sc1
L_noclr:
    s_mov_b64 exec, -1
    v_lshrrev_b32 v7, 5, v2
    v_lshlrev_b32 v7, 2, v7
    v_and_b32 v8, 1, v2
    v_lshl_add_u32 v7, v8, 3, v7
    v_bfe_u32 v8, v2, 1, 2
    v_lshl_add_u32 v170, v8, 4, v7
    v_lshl_add_u32 v171, v8, 11, v7
    buffer_load_dword v152, v171, s[8:11], s84 offen

    s_barrier
    s_cmp_lt_u32 s40, 4
    s_cbranch_scc1 L_kvd
    s_add_u32 m0, s88, 98304
    s_add_u32 s60, s89, 0
    buffer_load_dwordx4 v182, s[12:15], s60 offen nt lds
    s_add_u32 m0, s88, 99328
    s_add_u32 s60, s89, 1024
    buffer_load_dwordx4 v183, s[12:15], s60 offen nt lds
    s_add_u32 m0, s88, 100352
    s_add_u32 s60, s89, 2048
    buffer_load_dwordx4 v182, s[12:15], s60 offen nt lds
    s_add_u32 m0, s88, 101376
    s_add_u32 s60, s89, 3072
    buffer_load_dwordx4 v183, s[12:15], s60 offen nt lds
    s_add_u32 m0, s88, 102400
    s_add_u32 s60, s89, 4096
    buffer_load_dwordx4 v182, s[12:15], s60 offen nt lds
    s_add_u32 m0, s88, 103424
    s_add_u32 s60, s89, 5120
    buffer_load_dwordx4 v183, s[12:15], s60 offen nt lds
    s_add_u32 m0, s88, 104448
    s_add_u32 s60, s89, 6144
    buffer_load_dwordx4 v182, s[12:15], s60 offen nt lds
    s_add_u32 m0, s88, 105472
    s_add_u32 s60, s89, 7168
    buffer_load_dwordx4 v183, s[12:15], s60 offen nt lds
L_kvd:
    v_lshlrev_b32 v154, 4, v5
    v_lshl_add_u32 v154, v3, 7, v154
    v_lshl_add_u32 v154, v6, 9, v154
    s_and_b32 s76, s40, 3
    s_lshl_b32 s77, s76, 6
    v_lshl_add_u32 v178, v3, 4, s77
    v_lshl_add_u32 v155, v5, 16, v178
    v_lshl_add_u32 v156, v5, 11, v178
    s_lshl_b32 s77, s40, 11
    v_lshl_add_u32 v157, v2, 3, s77
    s_mul_i32 s77, s40, 272
    s_add_u32 s77, s77, 131072
    v_lshl_add_u32 v158, v2, 2, s77
    v_mul_u32_u24 v7, 272, v5
    v_add_u32 v7, 131072, v7
    v_lshl_add_u32 v159, v6, 6, v7
    v_lshl_add_u32 v159, v3, 4, v159
    s_lshl_b32 s77, s76, 6
    v_lshl_add_u32 v8, v3, 4, s77
    v_add_u32 v164, v7, v8
    s_lshl_b32 s77, s76, 2
    s_add_u32 s77, s77, 140544
    v_lshl_add_u32 v162, v5, 4, s77
    v_lshlrev_b32 v8, 2, v6
    v_lshl_add_u32 v8, v5, 4, v8
    v_add_u32 v163, 140544, v8
    s_lshl_b32 s77, s40, 11
    v_lshl_add_u32 v8, v6, 7, s77
    v_lshl_add_u32 v8, v3, 5, v8
    v_lshl_add_u32 v166, v5, 2, v8
    s_lshl_b32 s78, s72, 14
    s_sub_u32 s77, s77, s78
    s_and_b32 s78, s72, 1
    s_lshl_b32 s78, s78, 4
    s_add_u32 s77, s77, s78
    s_add_u32 s77, s77, 131072
    v_lshl_add_u32 v8, v5, 8, s77
    v_lshl_add_u32 v167, v3, 2, v8
    v_lshrrev_b32 v7, 1, v3
    s_lshl_b32 s77, s40, 14
    v_lshl_add_u32 v7, v7, 13, s77
    v_lshrrev_b32 v8, 2, v5
    v_lshl_add_u32 v7, v8, 12, v7
    v_and_b32 v8, 3, v5
    v_lshl_add_u32 v7, v8, 5, v7
    v_and_b32 v8, 1, v3
    v_lshl_add_u32 v168, v8, 4, v7
    v_lshrrev_b32 v7, 5, v2
    v_lshlrev_b32 v7, 4, v7
    v_lshl_add_u32 v7, v5, 5, v7
    s_lshl_b32 s77, s76, 2
    s_add_u32 s77, s77, 140288
    v_add_u32 v172, s77, v7
    s_lshl_b32 s77, s72, 5
    s_add_u32 s77, s77, 140288
    v_mov_b32 v173, s77
    s_lshl_b32 s77, s40, 5
    s_add_u32 s77, s77, 140288
    v_mov_b32 v174, s77
    v_bfe_u32 v7, v2, 2, 2
    v_bfe_u32 v8, v2, 1, 1
    v_and_b32 v9, 1, v2
    v_and_b32 v10, 1, v3
    v_lshl_add_u32 v11, v3, 3, v7
    v_lshrrev_b32 v12, 1, v7
    v_lshl_add_u32 v12, v10, 1, v12
    v_lshlrev_b32 v12, 1, v12
    s_lshl_b32 s77, s76, 1
    v_add_u32 v13, s77, v8
    v_xor_b32 v13, v13, v12
    v_lshlrev_b32 v13, 4, v13
    v_lshl_add_u32 v13, v9, 3, v13
    v_lshl_add_u32 v160, v11, 7, v13
    v_lshl_add_u32 v12, v10, 2, v7
    v_lshlrev_b32 v12, 1, v12
    s_lshl_b32 s77, s40, 1
    v_add_u32 v13, s77, v8
    v_xor_b32 v13, v13, v12
    v_lshlrev_b32 v13, 4, v13
    v_lshl_add_u32 v13, v9, 3, v13
    v_lshl_add_u32 v161, v11, 8, v13
    v_add_u32 v161, 0x10000, v161
    v_mov_b32 v144, 0x3f803f80
    v_mov_b32 v145, 0x3f803f80
    v_mov_b32 v146, 0x3f803f80
    v_mov_b32 v147, 0x3f803f80

    s_waitcnt vmcnt(8)
    s_cmp_ge_u32 s40, 4
    s_cbranch_scc1 L_w4
    s_waitcnt vmcnt(0)
L_w4:
    s_barrier
    s_waitcnt lgkmcnt(0)
    s_add_u32 s42, s42, 1
    s_and_b32 s42, s42, 0xff
    v_mov_b32 v175, s42
    s_cmp_ge_u32 s40, 4
    s_cbranch_scc1 L_v
    ds_read_b64_tr_b16 v[80:81], v160 offset:0
    ds_read_b64_tr_b16 v[82:83], v160 offset:512
    ds_read_b64_tr_b16 v[84:85], v160 offset:4096
    ds_read_b64_tr_b16 v[86:87], v160 offset:4608
    ds_read_b64_tr_b16 v[88:89], v160 offset:8192
    ds_read_b64_tr_b16 v[90:91], v160 offset:8704
    ds_read_b64_tr_b16 v[92:93], v160 offset:12288
    ds_read_b64_tr_b16 v[94:95], v160 offset:12800
    ds_read_b64_tr_b16 v[96:97], v160 offset:16384
    ds_read_b64_tr_b16 v[98:99], v160 offset:16896
    ds_read_b64_tr_b16 v[100:101], v160 offset:20480
    ds_read_b64_tr_b16 v[102:103], v160 offset:20992
    ds_read_b64_tr_b16 v[104:105], v160 offset:24576
    ds_read_b64_tr_b16 v[106:107], v160 offset:25088
    ds_read_b64_tr_b16 v[108:109], v160 offset:28672
    ds_read_b64_tr_b16 v[110:111], v160 offset:29184
    s_branch L_A
L_v:
    s_branch L_A
L_top:
    s_add_u32 s61, s46, s41
    s_cmp_lt_u32 s40, 4
    s_cbranch_scc1 sd_1
    s_sleep 4
sd_1:
    s_sleep 18
poll_2:
    buffer_load_dwordx4 v[186:189], v154, s[4:7], s61 offen offset:0 sc1
    buffer_load_dwordx4 v[190:193], v154, s[4:7], s61 offen offset:1024 sc1
    buffer_load_dwordx4 v[194:197], v154, s[4:7], s61 offen offset:2048 sc1
    buffer_load_dwordx4 v[198:201], v154, s[4:7], s61 offen offset:3072 sc1
    s_waitcnt vmcnt(0)
    v_max3_u32 v1, v186, v187, v188
    v_max3_u32 v1, v1, v189, v190
    v_max3_u32 v1, v1, v191, v192
    v_max3_u32 v1, v1, v193, v194
    v_max3_u32 v1, v1, v195, v196
    v_max3_u32 v1, v1, v197, v198
    v_max3_u32 v1, v1, v199, v200
    v_max_u32 v1, v1, v201
    v_cmp_eq_u32 vcc, -1, v1
    s_cbranch_vccz done_3
    s_sub_u32 s43, s43, 1
    s_cbranch_scc1 L_end
    s_sleep 1
    s_branch poll_2
done_3:
L_A:
    s_cmp_ge_u32 s40, 4
    s_cbranch_scc1 stat_4
    s_waitcnt lgkmcnt(0)
    v_mfma_f32_16x16x32_bf16 v[202:205], v[80:83], v[186:189], 0
    v_mfma_f32_16x16x32_bf16 v[206:209], v[84:87], v[186:189], 0
    v_mfma_f32_16x16x32_bf16 v[202:205], v[88:91], v[190:193], v[202:205]
    v_mfma_f32_16x16x32_bf16 v[206:209], v[92:95], v[190:193], v[206:209]
    v_mfma_f32_16x16x32_bf16 v[202:205], v[96:99], v[194:197], v[202:205]
    v_mfma_f32_16x16x32_bf16 v[206:209], v[100:103], v[194:197], v[206:209]
    v_mfma_f32_16x16x32_bf16 v[202:205], v[104:107], v[198:201], v[202:205]
    v_mfma_f32_16x16x32_bf16 v[206:209], v[108:111], v[198:201], v[206:209]
    s_add_u32 s60, s48, s41
    s_nop 7
    v_add_f32_dpp v202, v206, v202 row_ror:8 row_mask:0xf bank_mask:0xf
    v_add_f32_dpp v203, v207, v203 row_ror:8 row_mask:0xf bank_mask:0xf
    v_add_f32_dpp v204, v208, v204 row_ror:8 row_mask:0xf bank_mask:0xf
    v_add_f32_dpp v205, v209, v205 row_ror:8 row_mask:0xf bank_mask:0xf
    v_bfi_b32 v202, s44, v175, v202
    v_bfi_b32 v203, s44, v175, v203
    v_bfi_b32 v204, s44, v175, v204
    v_bfi_b32 v205, s44, v175, v205
    s_mov_b64 exec, s[68:69]
    buffer_store_dwordx4 v[202:205], v155, s[4:7], s60 offen sc1
    s_mov_b64 exec, -1
    s_cmp_lg_u32 s41, 0
    s_cbranch_scc1 p1e_5
    v_mfma_f32_16x16x32_bf16 v[206:209], v[80:83], v[144:147], 0
    v_mfma_f32_16x16x32_bf16 v[206:209], v[84:87], v[144:147], v[206:209]
    v_mfma_f32_16x16x32_bf16 v[206:209], v[88:91], v[144:147], v[206:209]
    v_mfma_f32_16x16x32_bf16 v[206:209], v[92:95], v[144:147], v[206:209]
    v_mfma_f32_16x16x32_bf16 v[206:209], v[96:99], v[144:147], v[206:209]
    v_mfma_f32_16x16x32_bf16 v[206:209], v[100:103], v[144:147], v[206:209]
    v_mfma_f32_16x16x32_bf16 v[206:209], v[104:107], v[144:147], v[206:209]
    v_mfma_f32_16x16x32_bf16 v[206:209], v[108:111], v[144:147], v[206:209]
    s_nop 7
    v_bfi_b32 v206, s44, v175, v206
    v_bfi_b32 v207, s44, v175, v207
    v_bfi_b32 v208, s44, v175, v208
    v_bfi_b32 v209, s44, v175, v209
    s_mov_b32 exec_lo, 0x00010001
    s_mov_b32 exec_hi, 0x00010001
    buffer_store_dwordx4 v[206:209], v178, s[4:7], s82 offen sc1
    s_mov_b64 exec, -1
    s_add_u32 m0, s88, 32768
    s_add_u32 s60, s89, 0
    buffer_load_dwordx4 v182, s[16:19], s60 offen nt lds
    s_add_u32 m0, s88, 33792
    s_add_u32 s60, s89, 1024
    buffer_load_dwordx4 v183, s[16:19], s60 offen nt lds
    s_add_u32 m0, s88, 34816
    s_add_u32 s60, s89, 2048
    buffer_load_dwordx4 v182, s[16:19], s60 offen nt lds
    s_add_u32 m0, s88, 35840
    s_add_u32 s60, s89, 3072
    buffer_load_dwordx4 v183, s[16:19], s60 offen nt lds
    s_add_u32 m0, s88, 36864
    s_add_u32 s60, s89, 4096
    buffer_load_dwordx4 v182, s[16:19], s60 offen nt lds
    s_add_u32 m0, s88, 37888
    s_add_u32 s60, s89, 5120
    buffer_load_dwordx4 v183, s[16:19], s60 offen nt lds
    s_add_u32 m0, s88, 38912
    s_add_u32 s60, s89, 6144
    buffer_load_dwordx4 v182, s[16:19], s60 offen nt lds
    s_add_u32 m0, s88, 39936
    s_add_u32 s60, s89, 7168
    buffer_load_dwordx4 v183, s[16:19], s60 offen nt lds
    s_branch p1e_5
stat_4:
    v_mov_b32 v1, 0
    v_mov_b32 v2, 0
    v_dot2c_f32_bf16 v1, v186, v144
    v_dot2c_f32_bf16 v2, v186, v186
    v_dot2c_f32_bf16 v1, v187, v144
    v_dot2c_f32_bf16 v2, v187, v187
    v_dot2c_f32_bf16 v1, v188, v144
    v_dot2c_f32_bf16 v2, v188, v188
    v_dot2c_f32_bf16 v1, v189, v144
    v_dot2c_f32_bf16 v2, v189, v189
    v_dot2c_f32_bf16 v1, v190, v144
    v_dot2c_f32_bf16 v2, v190, v190
    v_dot2c_f32_bf16 v1, v191, v144
    v_dot2c_f32_bf16 v2, v191, v191
    v_dot2c_f32_bf16 v1, v192, v144
    v_dot2c_f32_bf16 v2, v192, v192
    v_dot2c_f32_bf16 v1, v193, v144
    v_dot2c_f32_bf16 v2, v193, v193
    v_dot2c_f32_bf16 v1, v194, v144
    v_dot2c_f32_bf16 v2, v194, v194
    v_dot2c_f32_bf16 v1, v195, v144
    v_dot2c_f32_bf16 v2, v195, v195
    v_dot2c_f32_bf16 v1, v196, v144
    v_dot2c_f32_bf16 v2, v196, v196
    v_dot2c_f32_bf16 v1, v197, v144
    v_dot2c_f32_bf16 v2, v197, v197
    v_dot2c_f32_bf16 v1, v198, v144
    v_dot2c_f32_bf16 v2, v198, v198
    v_dot2c_f32_bf16 v1, v199, v144
    v_dot2c_f32_bf16 v2, v199, v199
    v_dot2c_f32_bf16 v1, v200, v144
    v_dot2c_f32_bf16 v2, v200, v200
    v_dot2c_f32_bf16 v1, v201, v144
    v_dot2c_f32_bf16 v2, v201, v201
    s_nop 2
    v_permlane32_swap_b32 v1, v2
    v_add_f32 v1, v1, v2
    v_mov_b32 v2, v1
    s_nop 1
    v_permlane16_swap_b32 v1, v2
    v_add_f32 v1, v1, v2
    s_nop 1
    v_add_f32_dpp v1, v1, v1 row_ror:8 row_mask:0xf bank_mask:0xf
    ds_write_b32 v172, v1

p1e_5:
    s_waitcnt lgkmcnt(0)
    s_barrier
    ds_read_b128 v[4:7], v173
    ds_read_b128 v[8:11], v173 offset:16
    s_waitcnt lgkmcnt(0)
    v_add_f32 v4, v4, v5
    v_add_f32 v6, v6, v7
    v_add_f32 v8, v8, v9
    v_add_f32 v10, v10, v11
    v_add_f32 v4, v4, v6
    v_add_f32 v8, v8, v10
    v_mul_f32 v210, 0x3a800000, v4
    v_mul_f32 v8, 0x3a800000, v8
    v_fma_f32 v8, -v210, v210, v8
    v_max_f32 v8, 0, v8
    v_add_f32 v8, 0x3727c5ac, v8
    v_rsq_f32 v211, v8

    s_add_u32 s61, s50, s41
    v_mov_b32 v194, v175
    v_mov_b32 v195, v175
    v_mov_b32 v196, v175
    v_mov_b32 v197, v175
    v_mov_b32 v198, v175
    v_mov_b32 v199, v175
    v_mov_b32 v200, v175
    v_mov_b32 v201, v175
    s_sleep 4
    s_cmp_lg_u32 s41, 0
    s_cbranch_scc1 ps_9
    s_sleep 20
ps_9:
poll_7:
    s_cmp_lg_u32 s41, 0
    s_cbranch_scc1 cs_6
    buffer_load_dwordx2 v[194:195], v157, s[4:7], s83 offen offset:0 sc1
    buffer_load_dwordx2 v[196:197], v157, s[4:7], s83 offen offset:512 sc1
    buffer_load_dwordx2 v[198:199], v157, s[4:7], s83 offen offset:1024 sc1
    buffer_load_dwordx2 v[200:201], v157, s[4:7], s83 offen offset:1536 sc1
cs_6:
    buffer_load_dwordx2 v[186:187], v157, s[4:7], s61 offen offset:0 sc1
    buffer_load_dwordx2 v[188:189], v157, s[4:7], s61 offen offset:512 sc1
    buffer_load_dwordx2 v[190:191], v157, s[4:7], s61 offen offset:1024 sc1
    buffer_load_dwordx2 v[192:193], v157, s[4:7], s61 offen offset:1536 sc1
    s_waitcnt vmcnt(0)
    v_bitop3_b32 v8, v186, v187, v175 bitop3:0x7e
    v_bitop3_b32 v7, v188, v189, v175 bitop3:0x7e
    v_bitop3_b32 v6, v190, v191, v175 bitop3:0x7e
    v_bitop3_b32 v5, v192, v193, v175 bitop3:0x7e
    v_bitop3_b32 v4, v194, v195, v175 bitop3:0x7e
    v_bitop3_b32 v3, v196, v197, v175 bitop3:0x7e
    v_bitop3_b32 v2, v198, v199, v175 bitop3:0x7e
    v_bitop3_b32 v1, v200, v201, v175 bitop3:0x7e
    v_or3_b32 v8, v8, v7, v6
    v_or3_b32 v5, v5, v4, v3
    v_or3_b32 v2, v2, v1, v8
    v_or_b32 v5, v5, v2
    v_and_b32 v5, 0xff, v5
    v_cmp_ne_u32 vcc, 0, v5
    s_cbranch_vccz done_8
    s_sub_u32 s43, s43, 1
    s_cbranch_scc1 L_end
    s_sleep 1
    s_branch poll_7
done_8:
    s_cmp_lg_u32 s41, 0
    s_cbranch_scc1 l0_10
    v_pk_add_f32 v[194:195], v[194:195], v[196:197]
    v_pk_add_f32 v[198:199], v[198:199], v[200:201]
    v_pk_add_f32 v[148:149], v[194:195], v[198:199]
l0_10:
    s_cmp_lg_u32 s41, 0
    s_cbranch_scc1 l0_11
    s_cmp_lt_u32 s40, 4
    s_cbranch_scc1 l0_11
    v_and_b32 v1, 7, v0
    v_lshlrev_b32 v1, 5, v1
    v_xor_b32 v1, v1, v181
    s_add_u32 s60, s88, 98304
    v_add_u32 v1, s60, v1

    v_xor_b32 v2, 0, v1
    ds_read_b128 v[80:83], v2 offset:0
    ds_read_b128 v[96:99], v2 offset:4096
    v_xor_b32 v2, 64, v1
    ds_read_b128 v[84:87], v2 offset:0
    ds_read_b128 v[100:103], v2 offset:4096
    v_xor_b32 v2, 128, v1
    ds_read_b128 v[88:91], v2 offset:0
    ds_read_b128 v[104:107], v2 offset:4096
    v_xor_b32 v2, 192, v1
    ds_read_b128 v[92:95], v2 offset:0
    ds_read_b128 v[108:111], v2 offset:4096
l0_11:
    v_pk_add_f32 v[186:187], v[186:187], v[188:189]
    v_pk_add_f32 v[190:191], v[190:191], v[192:193]
    v_pk_add_f32 v[186:187], v[186:187], v[190:191]
    v_fma_f32 v186, -v210, v148, v186
    v_fma_f32 v187, -v210, v149, v187
    v_mul_f32 v186, v211, v186
    v_mul_f32 v187, v211, v187
    v_cvt_pk_bf16_f32 v186, v186, v187
    ds_write_b32 v158, v186
    s_waitcnt lgkmcnt(0)
    s_barrier
    ds_read_b128 v[186:189], v159 offset:0
    ds_read_b128 v[190:193], v159 offset:128
    s_bitcmp1_b32 s67, 0
    s_cbranch_scc0 hk_13
    s_bitset0_b32 s67, 0
    s_add_u32 m0, s66, 65536
    s_add_u32 s60, s62, 0
    buffer_load_dwordx4 v176, s[24:27], s60 offen nt lds
    s_add_u32 m0, s66, 66560
    s_add_u32 s60, s62, 8192
    buffer_load_dwordx4 v176, s[24:27], s60 offen nt lds
    s_add_u32 m0, s66, 67584
    s_add_u32 s60, s62, 16384
    buffer_load_dwordx4 v177, s[24:27], s60 offen nt lds
    s_add_u32 m0, s66, 68608
    s_add_u32 s60, s62, 24576
    buffer_load_dwordx4 v177, s[24:27], s60 offen nt lds
hk_13:
    s_cmp_lt_u32 s40, 4
    s_cbranch_scc1 cmb_12
    s_waitcnt lgkmcnt(0)
    v_mfma_f32_16x16x32_bf16 v[194:197], v[80:83], v[186:189], 0
    v_mfma_f32_16x16x32_bf16 v[202:205], v[84:87], v[186:189], 0
    v_mfma_f32_16x16x32_bf16 v[198:201], v[96:99], v[186:189], 0
    v_mfma_f32_16x16x32_bf16 v[206:209], v[100:103], v[186:189], 0
    v_mfma_f32_16x16x32_bf16 v[194:197], v[88:91], v[190:193], v[194:197]
    v_mfma_f32_16x16x32_bf16 v[202:205], v[92:95], v[190:193], v[202:205]
    v_mfma_f32_16x16x32_bf16 v[198:201], v[104:107], v[190:193], v[198:201]
    v_mfma_f32_16x16x32_bf16 v[206:209], v[108:111], v[190:193], v[206:209]
    s_nop 5
    v_add_f32_dpp v194, v202, v194 row_ror:8 row_mask:0xf bank_mask:0xf
    v_add_f32_dpp v195, v203, v195 row_ror:8 row_mask:0xf bank_mask:0xf
    v_add_f32_dpp v196, v204, v196 row_ror:8 row_mask:0xf bank_mask:0xf
    v_add_f32_dpp v197, v205, v197 row_ror:8 row_mask:0xf bank_mask:0xf
    v_add_f32_dpp v198, v206, v198 row_ror:8 row_mask:0xf bank_mask:0xf
    v_add_f32_dpp v199, v207, v199 row_ror:8 row_mask:0xf bank_mask:0xf
    v_add_f32_dpp v200, v208, v200 row_ror:8 row_mask:0xf bank_mask:0xf
    v_add_f32_dpp v201, v209, v201 row_ror:8 row_mask:0xf bank_mask:0xf
    v_max3_f32 v1, v194, v195, v196
    v_max3_f32 v2, v197, v198, v199
    v_max3_f32 v1, v1, v200, v201
    v_max_f32 v1, v1, v2
    v_mov_b32 v2, v1
    s_nop 1
    v_permlane32_swap_b32 v1, v2
    v_max_f32 v1, v1, v2
    v_mov_b32 v2, v1
    s_nop 1
    v_permlane16_swap_b32 v1, v2
    v_max_f32 v1, v1, v2
    v_mul_f32 v2, s65, v1

    v_fma_f32 v194, v194, s65, -v2
    v_exp_f32 v194, v194
    v_fma_f32 v195, v195, s65, -v2
    v_exp_f32 v195, v195
    v_fma_f32 v196, v196, s65, -v2
    v_exp_f32 v196, v196
    v_fma_f32 v197, v197, s65, -v2
    v_exp_f32 v197, v197
    v_fma_f32 v198, v198, s65, -v2
    v_exp_f32 v198, v198
    v_fma_f32 v199, v199, s65, -v2
    v_exp_f32 v199, v199
    v_fma_f32 v200, v200, s65, -v2
    v_exp_f32 v200, v200
    v_fma_f32 v201, v201, s65, -v2
    v_exp_f32 v201, v201
    s_nop 0
    v_cvt_pk_bf16_f32 v186, v194, v195
    v_cvt_pk_bf16_f32 v187, v196, v197
    v_cvt_pk_bf16_f32 v188, v198, v199
    v_cvt_pk_bf16_f32 v189, v200, v201
    s_mov_b64 exec, s[68:69]
    ds_write_b32 v162, v2
    ds_write_b128 v164, v[186:189] offset:2304
    s_mov_b64 exec, -1
cmb_12:
    s_cmp_lg_u32 s41, 0
    s_cbranch_scc1 l0_14
    v_bfe_u32 v1, v0, 2, 4
    v_and_b32 v2, 7, v1
    v_xor_b32 v2, s40, v2
    v_lshlrev_b32 v2, 5, v2
    v_lshl_add_u32 v1, v1, 8, v2
    v_and_b32 v2, 3, v0
    v_lshl_add_u32 v1, v2, 3, v1

    ds_read_b64_tr_b16 v[16:17], v1 offset:32768
    ds_read_b64_tr_b16 v[18:19], v1 offset:36864
    ds_read_b64_tr_b16 v[20:21], v1 offset:40960
    ds_read_b64_tr_b16 v[22:23], v1 offset:45056
    ds_read_b64_tr_b16 v[24:25], v1 offset:49152
    ds_read_b64_tr_b16 v[26:27], v1 offset:53248
    ds_read_b64_tr_b16 v[28:29], v1 offset:57344
    ds_read_b64_tr_b16 v[30:31], v1 offset:61440
l0_14:
    s_waitcnt lgkmcnt(0)
    s_barrier
    ds_read2_b32 v[2:3], v163 offset1:2
    ds_read_b128 v[186:189], v159 offset:2304
    ds_read_b128 v[190:193], v159 offset:2432
    s_add_u32 s60, s52, s41
    s_add_u32 s61, s60, 131072
    v_lshrrev_b32 v12, 2, v169
    s_waitcnt lgkmcnt(1)
    v_mfma_f32_16x16x32_bf16 v[4:7], v[144:147], v[186:189], 0
    v_max_f32 v1, v2, v3
    s_waitcnt lgkmcnt(0)
    v_mfma_f32_16x16x32_bf16 v[8:11], v[144:147], v[190:193], 0
    v_mfma_f32_16x16x32_bf16 v[194:197], v[16:19], v[186:189], 0

    v_max_f32_dpp v1, v1, v1 row_ror:8 row_mask:0xf bank_mask:0xf
    v_mfma_f32_16x16x32_bf16 v[198:201], v[20:23], v[186:189], 0
    v_sub_f32 v2, v2, v1
    v_sub_f32 v3, v3, v1
    v_mfma_f32_16x16x32_bf16 v[202:205], v[24:27], v[190:193], 0
    v_exp_f32 v2, v2
    v_exp_f32 v3, v3

    v_mfma_f32_16x16x32_bf16 v[206:209], v[28:31], v[190:193], 0

    v_mul_f32 v4, v2, v4
    v_fmac_f32 v4, v3, v8

    v_mul_f32 v194, v2, v194
    v_mul_f32 v195, v2, v195
    v_mul_f32 v196, v2, v196
    v_mul_f32 v197, v2, v197
    v_add_f32_dpp v4, v4, v4 row_ror:8 row_mask:0xf bank_mask:0xf
    v_rcp_f32 v5, v4
    v_log_f32 v6, v4
    v_mul_f32 v198, v2, v198
    v_mul_f32 v199, v2, v199
    v_mul_f32 v200, v2, v200
    v_mul_f32 v201, v2, v201
    v_fmac_f32 v194, v202, v3
    v_fmac_f32 v195, v203, v3
    v_fmac_f32 v196, v204, v3
    v_fmac_f32 v197, v205, v3
    v_fmac_f32 v198, v206, v3
    v_fmac_f32 v199, v207, v3
    v_fmac_f32 v200, v208, v3
    v_fmac_f32 v201, v209, v3
    v_add_f32 v6, v6, v1
    s_nop 0
    v_add_f32_dpp v194, v198, v194 row_ror:8 row_mask:0xf bank_mask:0xf
    v_add_f32_dpp v195, v199, v195 row_ror:8 row_mask:0xf bank_mask:0xf
    v_add_f32_dpp v196, v200, v196 row_ror:8 row_mask:0xf bank_mask:0xf
    v_add_f32_dpp v197, v201, v197 row_ror:8 row_mask:0xf bank_mask:0xf
    v_mul_f32 v194, v5, v194
    v_mul_f32 v195, v5, v195
    v_mul_f32 v196, v5, v196
    v_mul_f32 v197, v5, v197
    v_cvt_pk_bf16_f32 v194, v194, v195
    v_cvt_pk_bf16_f32 v195, v196, v197
    s_mov_b64 exec, s[68:69]
    v_min_u32 v194, -2, v194
    v_min_u32 v195, -2, v195
    v_min_u32 v6, -2, v6
    buffer_store_dwordx2 v[194:195], v165, s[4:7], s60 offen sc1
    s_cmp_lg_u32 s40, 0
    s_cbranch_scc1 nolse_15
    s_mov_b64 exec, 0xff
    buffer_store_dword v6, v12, s[4:7], s61 offen sc1
nolse_15:
    s_mov_b64 exec, -1

    s_add_u32 s61, s53, s41
    s_sleep 10
    s_cmp_lg_u32 s41, 0
    s_cbranch_scc1 ps_18
    s_sleep 22
ps_18:
poll_16:
    buffer_load_dword v194, v167, s[4:7], s61 offen sc1
    buffer_load_dword v186, v166, s[4:7], s61 offen offset:0 sc1
    buffer_load_dword v187, v166, s[4:7], s61 offen offset:256 sc1
    buffer_load_dword v188, v166, s[4:7], s61 offen offset:512 sc1
    buffer_load_dword v189, v166, s[4:7], s61 offen offset:768 sc1
    buffer_load_dword v190, v166, s[4:7], s61 offen offset:1024 sc1
    buffer_load_dword v191, v166, s[4:7], s61 offen offset:1280 sc1
    buffer_load_dword v192, v166, s[4:7], s61 offen offset:1536 sc1
    buffer_load_dword v193, v166, s[4:7], s61 offen offset:1792 sc1
    s_bitcmp1_b32 s67, 1
    s_cbranch_scc0 hk_19
    s_bitset0_b32 s67, 1
    s_add_u32 m0, s66, 0
    s_add_u32 s60, s63, 0
    buffer_load_dwordx4 v180, s[28:31], s60 offen nt lds
    s_add_u32 m0, s66, 1024
    s_add_u32 s60, s63, 57344
    buffer_load_dwordx4 v179, s[28:31], s60 offen nt lds
    s_add_u32 m0, s66, 2048
    s_add_u32 s60, s63, 114688
    buffer_load_dwordx4 v180, s[28:31], s60 offen nt lds
    s_add_u32 m0, s66, 3072
    s_add_u32 s60, s63, 172032
    buffer_load_dwordx4 v179, s[28:31], s60 offen nt lds
    s_waitcnt vmcnt(4)
    s_branch hk_20
hk_19:
    s_waitcnt vmcnt(0)
hk_20:
    v_max3_u32 v1, v186, v187, v188
    v_max3_u32 v1, v1, v189, v190
    v_max3_u32 v1, v1, v191, v192
    v_max3_u32 v1, v1, v193, v194
    v_cmp_eq_u32 vcc, -1, v1
    s_cbranch_vccz done_17
    s_sub_u32 s43, s43, 1
    s_cbranch_scc1 L_end
    s_sleep 1
    s_branch poll_16
done_17:
    v_max_f32_dpp v1, v194, v194 quad_perm:[1,0,3,2] row_mask:0xf bank_mask:0xf
    v_lshlrev_b32 v196, 16, v186
    v_and_b32 v186, 0xffff0000, v186
    v_max_f32_dpp v1, v1, v1 quad_perm:[2,3,0,1] row_mask:0xf bank_mask:0xf
    v_lshlrev_b32 v197, 16, v187
    v_and_b32 v187, 0xffff0000, v187
    v_max_f32_dpp v1, v1, v1 row_half_mirror row_mask:0xf bank_mask:0xf
    v_sub_f32 v1, v194, v1
    v_exp_f32 v1, v1
    v_lshlrev_b32 v198, 16, v188
    v_and_b32 v188, 0xffff0000, v188
    v_add_f32_dpp v2, v1, v1 quad_perm:[1,0,3,2] row_mask:0xf bank_mask:0xf
    v_lshlrev_b32 v199, 16, v189
    v_and_b32 v189, 0xffff0000, v189
    v_add_f32_dpp v2, v2, v2 quad_perm:[2,3,0,1] row_mask:0xf bank_mask:0xf
    v_lshlrev_b32 v200, 16, v190
    v_and_b32 v190, 0xffff0000, v190
    v_add_f32_dpp v2, v2, v2 row_half_mirror row_mask:0xf bank_mask:0xf
    v_rcp_f32 v2, v2
    v_lshlrev_b32 v201, 16, v191
    v_and_b32 v191, 0xffff0000, v191
    v_lshlrev_b32 v202, 16, v192
    v_and_b32 v192, 0xffff0000, v192
    v_lshlrev_b32 v203, 16, v193
    v_and_b32 v193, 0xffff0000, v193
    v_mul_f32_dpp v3, v1, v196 row_newbcast:0 row_mask:0xf bank_mask:0xf
    v_mul_f32_dpp v4, v1, v186 row_newbcast:0 row_mask:0xf bank_mask:0xf

    v_fmac_f32_dpp v3, v1, v197 row_newbcast:1 row_mask:0xf bank_mask:0xf
    v_fmac_f32_dpp v4, v1, v187 row_newbcast:1 row_mask:0xf bank_mask:0xf
    v_fmac_f32_dpp v3, v1, v198 row_newbcast:2 row_mask:0xf bank_mask:0xf
    v_fmac_f32_dpp v4, v1, v188 row_newbcast:2 row_mask:0xf bank_mask:0xf
    v_fmac_f32_dpp v3, v1, v199 row_newbcast:3 row_mask:0xf bank_mask:0xf
    v_fmac_f32_dpp v4, v1, v189 row_newbcast:3 row_mask:0xf bank_mask:0xf
    v_fmac_f32_dpp v3, v1, v200 row_newbcast:4 row_mask:0xf bank_mask:0xf
    v_fmac_f32_dpp v4, v1, v190 row_newbcast:4 row_mask:0xf bank_mask:0xf
    v_fmac_f32_dpp v3, v1, v201 row_newbcast:5 row_mask:0xf bank_mask:0xf
    v_fmac_f32_dpp v4, v1, v191 row_newbcast:5 row_mask:0xf bank_mask:0xf
    v_fmac_f32_dpp v3, v1, v202 row_newbcast:6 row_mask:0xf bank_mask:0xf
    v_fmac_f32_dpp v4, v1, v192 row_newbcast:6 row_mask:0xf bank_mask:0xf
    v_fmac_f32_dpp v3, v1, v203 row_newbcast:7 row_mask:0xf bank_mask:0xf
    v_fmac_f32_dpp v4, v1, v193 row_newbcast:7 row_mask:0xf bank_mask:0xf
    v_mul_f32 v3, v2, v3
    v_mul_f32 v4, v2, v4
    v_cvt_pk_bf16_f32 v3, v3, v4
    ds_write_b32 v158, v3 offset:4608
    s_waitcnt lgkmcnt(0)
    s_barrier
    ds_read_b128 v[186:189], v159 offset:4608
    ds_read_b128 v[190:193], v159 offset:4736
    s_cmp_lg_u32 s41, 0
    s_cbranch_scc1 l0_21
    ds_read_b64_tr_b16 v[48:49], v161 offset:0
    ds_read_b64_tr_b16 v[50:51], v161 offset:1024
    ds_read_b64_tr_b16 v[52:53], v161 offset:8192
    ds_read_b64_tr_b16 v[54:55], v161 offset:9216
    ds_read_b64_tr_b16 v[56:57], v161 offset:16384
    ds_read_b64_tr_b16 v[58:59], v161 offset:17408
    ds_read_b64_tr_b16 v[60:61], v161 offset:24576
    ds_read_b64_tr_b16 v[62:63], v161 offset:25600
l0_21:
    s_waitcnt lgkmcnt(0)
    v_mfma_f32_16x16x32_bf16 v[202:205], v[48:51], v[186:189], 0
    v_mfma_f32_16x16x32_bf16 v[206:209], v[52:55], v[186:189], 0
    v_mfma_f32_16x16x32_bf16 v[202:205], v[56:59], v[190:193], v[202:205]
    v_mfma_f32_16x16x32_bf16 v[206:209], v[60:63], v[190:193], v[206:209]
    s_add_u32 s60, s54, s41
    s_nop 7
    v_add_f32_dpp v202, v206, v202 row_ror:8 row_mask:0xf bank_mask:0xf
    v_add_f32_dpp v203, v207, v203 row_ror:8 row_mask:0xf bank_mask:0xf
    v_add_f32_dpp v204, v208, v204 row_ror:8 row_mask:0xf bank_mask:0xf
    v_add_f32_dpp v205, v209, v205 row_ror:8 row_mask:0xf bank_mask:0xf
    v_bfi_b32 v202, s44, v175, v202
    v_bfi_b32 v203, s44, v175, v203
    v_bfi_b32 v204, s44, v175, v204
    v_bfi_b32 v205, s44, v175, v205
    s_mov_b64 exec, s[68:69]
    buffer_store_dwordx4 v[202:205], v168, s[4:7], s60 offen sc1
    s_mov_b64 exec, -1
p3e_22:
    s_bitcmp1_b32 s67, 2
    s_cbranch_scc0 hk_23
    s_bitset0_b32 s67, 2
    s_add_u32 m0, s66, 98304
    s_add_u32 s60, s64, 0
    buffer_load_dwordx4 v176, s[32:35], s60 offen nt lds
    s_add_u32 m0, s66, 99328
    s_add_u32 s60, s64, 8192
    buffer_load_dwordx4 v176, s[32:35], s60 offen nt lds
    s_add_u32 m0, s66, 100352
    s_add_u32 s60, s64, 16384
    buffer_load_dwordx4 v177, s[32:35], s60 offen nt lds
    s_add_u32 m0, s66, 101376
    s_add_u32 s60, s64, 24576
    buffer_load_dwordx4 v177, s[32:35], s60 offen nt lds
hk_23:
    s_cmp_lg_u32 s40, 0
    s_cbranch_scc1 r1e_24
    s_add_u32 s61, s56, s41
    v_lshlrev_b32 v202, 16, v152
    v_and_b32 v203, 0xffff0000, v152
    s_sleep 13
poll_25:
    buffer_load_dwordx4 v[186:189], v169, s[4:7], s61 offen offset:0 sc1
    buffer_load_dwordx4 v[190:193], v169, s[4:7], s61 offen offset:1024 sc1
    buffer_load_dwordx4 v[194:197], v169, s[4:7], s61 offen offset:2048 sc1
    buffer_load_dwordx4 v[198:201], v169, s[4:7], s61 offen offset:3072 sc1
    s_waitcnt vmcnt(0)
    v_bitop3_b32 v8, v186, v187, v175 bitop3:0x7e
    v_bitop3_b32 v7, v188, v189, v175 bitop3:0x7e
    v_bitop3_b32 v6, v190, v191, v175 bitop3:0x7e
    v_bitop3_b32 v5, v192, v193, v175 bitop3:0x7e
    v_bitop3_b32 v4, v194, v195, v175 bitop3:0x7e
    v_bitop3_b32 v3, v196, v197, v175 bitop3:0x7e
    v_bitop3_b32 v2, v198, v199, v175 bitop3:0x7e
    v_bitop3_b32 v1, v200, v201, v175 bitop3:0x7e
    v_or3_b32 v8, v8, v7, v6
    v_or3_b32 v5, v5, v4, v3
    v_or3_b32 v2, v2, v1, v8
    v_or_b32 v5, v5, v2
    v_and_b32 v5, 0xff, v5
    v_cmp_ne_u32 vcc, 0, v5
    s_cbranch_vccz done_26
    s_sub_u32 s43, s43, 1
    s_cbranch_scc1 L_end
    s_sleep 1
    s_branch poll_25
done_26:
    v_pk_add_f32 v[186:187], v[186:187], v[190:191]
    v_pk_add_f32 v[188:189], v[188:189], v[192:193]
    v_pk_add_f32 v[194:195], v[194:195], v[198:199]
    v_pk_add_f32 v[196:197], v[196:197], v[200:201]
    v_pk_add_f32 v[186:187], v[186:187], v[194:195]
    v_pk_add_f32 v[188:189], v[188:189], v[196:197]
    s_nop 1
    v_permlane32_swap_b32 v186, v188
    v_permlane32_swap_b32 v187, v189
    v_add_f32 v186, v186, v188
    v_add_f32 v187, v187, v189
    v_mov_b32 v188, v186
    v_mov_b32 v189, v187
    s_nop 0
    v_permlane16_swap_b32 v186, v188
    v_permlane16_swap_b32 v187, v189
    v_add_f32 v186, v186, v188
    v_add_f32 v187, v187, v189
    s_nop 0
    v_add_f32_dpp v186, v186, v186 row_ror:8 row_mask:0xf bank_mask:0xf
    v_add_f32_dpp v187, v187, v187 row_ror:8 row_mask:0xf bank_mask:0xf
    v_cvt_pk_bf16_f32 v186, v186, v187
    v_lshlrev_b32 v187, 16, v186
    v_and_b32 v186, 0xffff0000, v186
    v_add_f32 v190, v202, v187
    v_add_f32 v191, v203, v186
    v_cvt_pk_bf16_f32 v152, v190, v191
    v_min_u32 v152, -2, v152

    s_add_u32 s60, s58, s41
    s_mov_b64 exec, s[70:71]
    buffer_store_dword v152, v170, s[4:7], s60 offen sc1
    s_mov_b64 exec, -1
r1e_24:
    s_waitcnt vmcnt(4)
    s_barrier
    s_cmp_lg_u32 s41, 0
    s_cbranch_scc1 l0_27
    s_cmp_ge_u32 s40, 4
    s_cbranch_scc1 l0_27
    s_cmp_eq_u32 s45, 0
    s_cbranch_scc1 l0_27
    ds_read_b64_tr_b16 v[112:113], v160 offset:0
    ds_read_b64_tr_b16 v[114:115], v160 offset:512
    ds_read_b64_tr_b16 v[116:117], v160 offset:4096
    ds_read_b64_tr_b16 v[118:119], v160 offset:4608
    ds_read_b64_tr_b16 v[120:121], v160 offset:8192
    ds_read_b64_tr_b16 v[122:123], v160 offset:8704
    ds_read_b64_tr_b16 v[124:125], v160 offset:12288
    ds_read_b64_tr_b16 v[126:127], v160 offset:12800
    ds_read_b64_tr_b16 v[128:129], v160 offset:16384
    ds_read_b64_tr_b16 v[130:131], v160 offset:16896
    ds_read_b64_tr_b16 v[132:133], v160 offset:20480
    ds_read_b64_tr_b16 v[134:135], v160 offset:20992
    ds_read_b64_tr_b16 v[136:137], v160 offset:24576
    ds_read_b64_tr_b16 v[138:139], v160 offset:25088
    ds_read_b64_tr_b16 v[140:141], v160 offset:28672
    ds_read_b64_tr_b16 v[142:143], v160 offset:29184
    s_waitcnt lgkmcnt(0)
    v_mfma_f32_16x16x32_bf16 v[206:209], v[112:115], v[144:147], 0
    v_mfma_f32_16x16x32_bf16 v[206:209], v[116:119], v[144:147], v[206:209]
    v_mfma_f32_16x16x32_bf16 v[206:209], v[120:123], v[144:147], v[206:209]
    v_mfma_f32_16x16x32_bf16 v[206:209], v[124:127], v[144:147], v[206:209]
    v_mfma_f32_16x16x32_bf16 v[206:209], v[128:131], v[144:147], v[206:209]
    v_mfma_f32_16x16x32_bf16 v[206:209], v[132:135], v[144:147], v[206:209]
    v_mfma_f32_16x16x32_bf16 v[206:209], v[136:139], v[144:147], v[206:209]
    v_mfma_f32_16x16x32_bf16 v[206:209], v[140:143], v[144:147], v[206:209]
    s_nop 7
    v_bfi_b32 v206, s44, v175, v206
    v_bfi_b32 v207, s44, v175, v207
    v_bfi_b32 v208, s44, v175, v208
    v_bfi_b32 v209, s44, v175, v209
    s_mov_b32 exec_lo, 0x00010001
    s_mov_b32 exec_hi, 0x00010001
    buffer_store_dwordx4 v[206:209], v178, s[4:7], s86 offen sc1
    s_mov_b64 exec, -1
l0_27:
    s_add_u32 s61, s47, s41
    s_cmp_lt_u32 s40, 4
    s_cbranch_scc1 sd_28
    s_sleep 4
sd_28:
    s_sleep 10
    s_cmp_eq_u32 s41, 0
    s_cbranch_scc1 ps_31
    s_sleep 8
ps_31:
poll_29:
    buffer_load_dwordx4 v[186:189], v154, s[4:7], s61 offen offset:0 sc1
    buffer_load_dwordx4 v[190:193], v154, s[4:7], s61 offen offset:1024 sc1
    buffer_load_dwordx4 v[194:197], v154, s[4:7], s61 offen offset:2048 sc1
    buffer_load_dwordx4 v[198:201], v154, s[4:7], s61 offen offset:3072 sc1
    s_waitcnt vmcnt(0)
    v_max3_u32 v1, v186, v187, v188
    v_max3_u32 v1, v1, v189, v190
    v_max3_u32 v1, v1, v191, v192
    v_max3_u32 v1, v1, v193, v194
    v_max3_u32 v1, v1, v195, v196
    v_max3_u32 v1, v1, v197, v198
    v_max3_u32 v1, v1, v199, v200
    v_max_u32 v1, v1, v201
    v_cmp_eq_u32 vcc, -1, v1
    s_cbranch_vccz done_30
    s_sub_u32 s43, s43, 1
    s_cbranch_scc1 L_end
    s_sleep 1
    s_branch poll_29
done_30:
    s_cmp_ge_u32 s40, 4
    s_cbranch_scc1 stat_32
    s_waitcnt lgkmcnt(0)
    v_mfma_f32_16x16x32_bf16 v[202:205], v[112:115], v[186:189], 0
    v_mfma_f32_16x16x32_bf16 v[206:209], v[116:119], v[186:189], 0
    v_mfma_f32_16x16x32_bf16 v[202:205], v[120:123], v[190:193], v[202:205]
    v_mfma_f32_16x16x32_bf16 v[206:209], v[124:127], v[190:193], v[206:209]
    v_mfma_f32_16x16x32_bf16 v[202:205], v[128:131], v[194:197], v[202:205]
    v_mfma_f32_16x16x32_bf16 v[206:209], v[132:135], v[194:197], v[206:209]
    v_mfma_f32_16x16x32_bf16 v[202:205], v[136:139], v[198:201], v[202:205]
    v_mfma_f32_16x16x32_bf16 v[206:209], v[140:143], v[198:201], v[206:209]
    s_add_u32 s60, s49, s41
    s_nop 7
    v_add_f32_dpp v202, v206, v202 row_ror:8 row_mask:0xf bank_mask:0xf
    v_add_f32_dpp v203, v207, v203 row_ror:8 row_mask:0xf bank_mask:0xf
    v_add_f32_dpp v204, v208, v204 row_ror:8 row_mask:0xf bank_mask:0xf
    v_add_f32_dpp v205, v209, v205 row_ror:8 row_mask:0xf bank_mask:0xf
    v_bfi_b32 v202, s44, v175, v202
    v_bfi_b32 v203, s44, v175, v203
    v_bfi_b32 v204, s44, v175, v204
    v_bfi_b32 v205, s44, v175, v205
    s_cmp_eq_u32 s45, 0
    s_cbranch_scc1 p1e_33
    s_mov_b64 exec, s[68:69]
    buffer_store_dwordx4 v[202:205], v156, s[4:7], s60 offen sc1
    s_mov_b64 exec, -1
    s_branch p1e_33
stat_32:
    v_mov_b32 v1, 0
    v_mov_b32 v2, 0
    v_dot2c_f32_bf16 v1, v186, v144
    v_dot2c_f32_bf16 v2, v186, v186
    v_dot2c_f32_bf16 v1, v187, v144
    v_dot2c_f32_bf16 v2, v187, v187
    v_dot2c_f32_bf16 v1, v188, v144
    v_dot2c_f32_bf16 v2, v188, v188
    v_dot2c_f32_bf16 v1, v189, v144
    v_dot2c_f32_bf16 v2, v189, v189
    v_dot2c_f32_bf16 v1, v190, v144
    v_dot2c_f32_bf16 v2, v190, v190
    v_dot2c_f32_bf16 v1, v191, v144
    v_dot2c_f32_bf16 v2, v191, v191
    v_dot2c_f32_bf16 v1, v192, v144
    v_dot2c_f32_bf16 v2, v192, v192
    v_dot2c_f32_bf16 v1, v193, v144
    v_dot2c_f32_bf16 v2, v193, v193
    v_dot2c_f32_bf16 v1, v194, v144
    v_dot2c_f32_bf16 v2, v194, v194
    v_dot2c_f32_bf16 v1, v195, v144
    v_dot2c_f32_bf16 v2, v195, v195
    v_dot2c_f32_bf16 v1, v196, v144
    v_dot2c_f32_bf16 v2, v196, v196
    v_dot2c_f32_bf16 v1, v197, v144
    v_dot2c_f32_bf16 v2, v197, v197
    v_dot2c_f32_bf16 v1, v198, v144
    v_dot2c_f32_bf16 v2, v198, v198
    v_dot2c_f32_bf16 v1, v199, v144
    v_dot2c_f32_bf16 v2, v199, v199
    v_dot2c_f32_bf16 v1, v200, v144
    v_dot2c_f32_bf16 v2, v200, v200
    v_dot2c_f32_bf16 v1, v201, v144
    v_dot2c_f32_bf16 v2, v201, v201
    s_nop 2
    v_permlane32_swap_b32 v1, v2
    v_add_f32 v1, v1, v2
    v_mov_b32 v2, v1
    s_nop 1
    v_permlane16_swap_b32 v1, v2
    v_add_f32 v1, v1, v2
    s_nop 1
    v_add_f32_dpp v1, v1, v1 row_ror:8 row_mask:0xf bank_mask:0xf
    ds_write_b32 v172, v1

p1e_33:
    s_waitcnt lgkmcnt(0)
    s_barrier
    s_cmp_lg_u32 s41, 0
    s_cbranch_scc1 l0_34
    ds_read_b64_tr_b16 v[64:65], v161 offset:32768
    ds_read_b64_tr_b16 v[66:67], v161 offset:33792
    ds_read_b64_tr_b16 v[68:69], v161 offset:40960
    ds_read_b64_tr_b16 v[70:71], v161 offset:41984
    ds_read_b64_tr_b16 v[72:73], v161 offset:49152
    ds_read_b64_tr_b16 v[74:75], v161 offset:50176
    ds_read_b64_tr_b16 v[76:77], v161 offset:57344
    ds_read_b64_tr_b16 v[78:79], v161 offset:58368
l0_34:
    ds_read_b128 v[4:7], v174
    ds_read_b128 v[8:11], v174 offset:16
    s_waitcnt lgkmcnt(0)
    v_add_f32 v4, v4, v5
    v_add_f32 v6, v6, v7
    v_add_f32 v8, v8, v9
    v_add_f32 v10, v10, v11
    v_add_f32 v4, v4, v6
    v_add_f32 v8, v8, v10
    v_mul_f32 v210, 0x3a800000, v4
    v_mul_f32 v8, 0x3a800000, v8
    v_fma_f32 v8, -v210, v210, v8
    v_max_f32 v8, 0, v8
    v_add_f32 v8, 0x3727c5ac, v8
    v_rsq_f32 v211, v8

    s_add_u32 s61, s51, s41
    v_lshrrev_b32 v15, 1, v169
    v_mov_b32 v194, v175
    v_mov_b32 v195, v175
    v_mov_b32 v196, v175
    v_mov_b32 v197, v175
    v_mov_b32 v198, v175
    v_mov_b32 v199, v175
    v_mov_b32 v200, v175
    v_mov_b32 v201, v175
    s_sleep 4
poll_36:
    s_cmp_lg_u32 s41, 0
    s_cbranch_scc1 cs_35
    buffer_load_dwordx2 v[194:195], v15, s[4:7], s87 offen offset:0 sc1
    buffer_load_dwordx2 v[196:197], v15, s[4:7], s87 offen offset:512 sc1
    buffer_load_dwordx2 v[198:199], v15, s[4:7], s87 offen offset:1024 sc1
    buffer_load_dwordx2 v[200:201], v15, s[4:7], s87 offen offset:1536 sc1
cs_35:
    buffer_load_dwordx2 v[186:187], v157, s[4:7], s61 offen offset:0 sc1
    buffer_load_dwordx2 v[188:189], v157, s[4:7], s61 offen offset:512 sc1
    buffer_load_dwordx2 v[190:191], v157, s[4:7], s61 offen offset:1024 sc1
    buffer_load_dwordx2 v[192:193], v157, s[4:7], s61 offen offset:1536 sc1
    s_waitcnt vmcnt(0)
    v_bitop3_b32 v8, v186, v187, v175 bitop3:0x7e
    v_bitop3_b32 v7, v188, v189, v175 bitop3:0x7e
    v_bitop3_b32 v6, v190, v191, v175 bitop3:0x7e
    v_bitop3_b32 v5, v192, v193, v175 bitop3:0x7e
    v_bitop3_b32 v4, v194, v195, v175 bitop3:0x7e
    v_bitop3_b32 v3, v196, v197, v175 bitop3:0x7e
    v_bitop3_b32 v2, v198, v199, v175 bitop3:0x7e
    v_bitop3_b32 v1, v200, v201, v175 bitop3:0x7e
    v_or3_b32 v8, v8, v7, v6
    v_or3_b32 v5, v5, v4, v3
    v_or3_b32 v2, v2, v1, v8
    v_or_b32 v5, v5, v2
    v_and_b32 v5, 0xff, v5
    v_cmp_ne_u32 vcc, 0, v5
    s_cbranch_vccz done_37
    s_sub_u32 s43, s43, 1
    s_cbranch_scc1 L_end
    s_sleep 1
    s_branch poll_36
done_37:
    s_cmp_lg_u32 s41, 0
    s_cbranch_scc1 l0_38
    v_pk_add_f32 v[194:195], v[194:195], v[196:197]
    v_pk_add_f32 v[198:199], v[198:199], v[200:201]
    v_pk_add_f32 v[150:151], v[194:195], v[198:199]
l0_38:
    v_pk_add_f32 v[186:187], v[186:187], v[188:189]
    v_pk_add_f32 v[190:191], v[190:191], v[192:193]
    v_pk_add_f32 v[186:187], v[186:187], v[190:191]
    v_fma_f32 v186, -v210, v150, v186
    v_fma_f32 v187, -v210, v151, v187
    v_mul_f32 v186, v211, v186
    v_mul_f32 v187, v211, v187
    v_mul_f32 v1, 0xbfb8aa3b, v186
    v_mul_f32 v2, 0xbfb8aa3b, v187
    v_exp_f32 v1, v1
    v_exp_f32 v2, v2
    s_nop 0
    v_add_f32 v1, 1.0, v1
    v_add_f32 v2, 1.0, v2
    v_rcp_f32 v1, v1
    v_rcp_f32 v2, v2
    s_nop 0
    v_mul_f32 v1, v1, v186
    v_mul_f32 v2, v2, v187
    v_cvt_pk_bf16_f32 v1, v1, v2
    ds_write_b32 v158, v1 offset:6912

    s_waitcnt lgkmcnt(0)
    s_barrier
    ds_read_b128 v[186:189], v159 offset:6912
    ds_read_b128 v[190:193], v159 offset:7040
    s_waitcnt lgkmcnt(0)
    v_mfma_f32_16x16x32_bf16 v[202:205], v[64:67], v[186:189], 0
    v_mfma_f32_16x16x32_bf16 v[206:209], v[68:71], v[186:189], 0
    v_mfma_f32_16x16x32_bf16 v[202:205], v[72:75], v[190:193], v[202:205]
    v_mfma_f32_16x16x32_bf16 v[206:209], v[76:79], v[190:193], v[206:209]
    s_add_u32 s60, s55, s41
    s_nop 7
    v_add_f32_dpp v202, v206, v202 row_ror:8 row_mask:0xf bank_mask:0xf
    v_add_f32_dpp v203, v207, v203 row_ror:8 row_mask:0xf bank_mask:0xf
    v_add_f32_dpp v204, v208, v204 row_ror:8 row_mask:0xf bank_mask:0xf
    v_add_f32_dpp v205, v209, v205 row_ror:8 row_mask:0xf bank_mask:0xf
    v_bfi_b32 v202, s44, v175, v202
    v_bfi_b32 v203, s44, v175, v203
    v_bfi_b32 v204, s44, v175, v204
    v_bfi_b32 v205, s44, v175, v205
    s_cmp_eq_u32 s45, 0
    s_cbranch_scc1 p3e_39
    s_mov_b64 exec, s[68:69]
    buffer_store_dwordx4 v[202:205], v168, s[4:7], s60 offen sc1
    s_mov_b64 exec, -1
p3e_39:
    s_cmp_lg_u32 s40, 0
    s_cbranch_scc1 r2e_40
    s_add_u32 s61, s57, s41
    v_mov_b32 v198, v175
    v_mov_b32 v199, v175
    v_mov_b32 v200, v175
    v_mov_b32 v201, v175
    v_lshlrev_b32 v202, 16, v152
    v_and_b32 v203, 0xffff0000, v152
    s_sleep 13
poll_41:
    buffer_load_dwordx4 v[186:189], v169, s[4:7], s61 offen offset:0 sc1
    buffer_load_dwordx4 v[190:193], v169, s[4:7], s61 offen offset:1024 sc1
    buffer_load_dwordx4 v[194:197], v169, s[4:7], s61 offen offset:2048 sc1
    s_mov_b32 exec_hi, 0
    buffer_load_dwordx4 v[198:201], v169, s[4:7], s61 offen offset:3072 sc1
    s_mov_b32 exec_hi, -1
    s_waitcnt vmcnt(0)
    v_bitop3_b32 v8, v186, v187, v175 bitop3:0x7e
    v_bitop3_b32 v7, v188, v189, v175 bitop3:0x7e
    v_bitop3_b32 v6, v190, v191, v175 bitop3:0x7e
    v_bitop3_b32 v5, v192, v193, v175 bitop3:0x7e
    v_bitop3_b32 v4, v194, v195, v175 bitop3:0x7e
    v_bitop3_b32 v3, v196, v197, v175 bitop3:0x7e
    v_bitop3_b32 v2, v198, v199, v175 bitop3:0x7e
    v_bitop3_b32 v1, v200, v201, v175 bitop3:0x7e
    v_or3_b32 v8, v8, v7, v6
    v_or3_b32 v5, v5, v4, v3
    v_or3_b32 v2, v2, v1, v8
    v_or_b32 v5, v5, v2
    v_and_b32 v5, 0xff, v5
    v_cmp_ne_u32 vcc, 0, v5
    s_cbranch_vccz done_42
    s_sub_u32 s43, s43, 1
    s_cbranch_scc1 L_end
    s_sleep 1
    s_branch poll_41
done_42:
    v_pk_add_f32 v[186:187], v[186:187], v[190:191]
    v_pk_add_f32 v[188:189], v[188:189], v[192:193]
    v_pk_add_f32 v[194:195], v[194:195], v[198:199]
    v_pk_add_f32 v[196:197], v[196:197], v[200:201]
    v_pk_add_f32 v[186:187], v[186:187], v[194:195]
    v_pk_add_f32 v[188:189], v[188:189], v[196:197]
    s_nop 1
    v_permlane32_swap_b32 v186, v188
    v_permlane32_swap_b32 v187, v189
    v_add_f32 v186, v186, v188
    v_add_f32 v187, v187, v189
    v_mov_b32 v188, v186
    v_mov_b32 v189, v187
    s_nop 0
    v_permlane16_swap_b32 v186, v188
    v_permlane16_swap_b32 v187, v189
    v_add_f32 v186, v186, v188
    v_add_f32 v187, v187, v189
    s_nop 0
    v_add_f32_dpp v186, v186, v186 row_ror:8 row_mask:0xf bank_mask:0xf
    v_add_f32_dpp v187, v187, v187 row_ror:8 row_mask:0xf bank_mask:0xf
    v_cvt_pk_bf16_f32 v186, v186, v187
    v_lshlrev_b32 v187, 16, v186
    v_and_b32 v186, 0xffff0000, v186
    v_add_f32 v190, v202, v187
    v_add_f32 v191, v203, v186
    v_cvt_pk_bf16_f32 v152, v190, v191
    v_min_u32 v152, -2, v152

    s_mov_b64 exec, s[70:71]
    s_cmp_lg_u32 s41, 0
    s_cbranch_scc1 L_fin
    buffer_store_dword v152, v170, s[4:7], s59 offen sc1
    s_mov_b64 exec, -1
r2e_40:
    s_cmp_lg_u32 s41, 0
    s_cbranch_scc1 L_end
    s_barrier
    s_mov_b32 s41, 4194304
    s_branch L_top
L_fin:
    buffer_store_dword v152, v171, s[36:39], s84 offen
    s_cmp_lg_u32 s2, 0
    s_cbranch_scc1 L_end
    s_mov_b64 exec, 1
    v_mov_b32 v1, 0
    buffer_store_dword v175, v1, s[4:7], 0 offen
L_end:
L_exit:
    s_endpgm
.section .rodata,"a"
.p2align 6
.amdhsa_kernel interleave_layers__sliding_block_cached__dense_activation_silu__decode_kernel
  .amdhsa_next_free_vgpr 256
  .amdhsa_next_free_sgpr 102
  .amdhsa_accum_offset 256
  .amdhsa_group_segment_fixed_size 0
  .amdhsa_kernarg_size 88
  .amdhsa_user_sgpr_count 2
  .amdhsa_user_sgpr_kernarg_segment_ptr 1
  .amdhsa_system_sgpr_workgroup_id_x 1
.end_amdhsa_kernel
```
